```python
import torch

def _softmax(x, axis=-1):
    return torch.softmax(x, dim=axis)

def _gelu(x):
    return torch.nn.functional.gelu(x, approximate='tanh')

def _silu(x):
    return torch.nn.functional.silu(x)

def _sigmoid(x):
    return torch.sigmoid(x)

def _layernorm(x, axis=-1, eps=1e-05):
    m = x.mean(dim=axis, keepdim=True)
    v = x.var(dim=axis, keepdim=True, unbiased=False)
    return (x - m) / torch.sqrt(v + eps)

def _scatter_add(tgt, idx, src, axis=0):
    return tgt.clone().index_add_(axis, idx, src)

def _segment_sum(src, seg, n):
    out = torch.zeros((n,) + src.shape[1:], dtype=src.dtype)
    return out.index_add_(0, seg, src)

def _pad(x, pw):
    flat = tuple((v for pair in reversed(pw) for v in pair))
    return torch.nn.functional.pad(x, flat)
kernel_name = 'standalone__tree_speculative_verify_tree_attention_over_candidate_token_tree__decode'

def setup_inputs():

    _w = lambda a: (lambda t: t.to(torch.bfloat16) if t.is_floating_point() else t)(torch.as_tensor(a))
    B, Hq, Hkv, T, C, D = (1, 32, 16, 1, 8192, 128)
    tree_mask = torch.zeros((B, T, T), dtype=float)
    for b in range(B):
        parent = torch.zeros(T, dtype=torch.int64)
        for i in range(1, T):
            parent[i] = int(torch.randint(0, i, (1,)).item())
        for i in range(T):
            j = i
            tree_mask[b, i, j] = 1.0
            while j > 0:
                j = parent[j]
                tree_mask[b, i, j] = 1.0
    return {'q': _w((lambda *s: torch.randn(*s, dtype=torch.bfloat16) * 0.8)(B, Hq, T, D)), 'k_cache': _w((lambda *s: torch.randn(*s, dtype=torch.bfloat16) * 0.8)(B, Hkv, C, D)), 'v_cache': _w((lambda *s: torch.randn(*s, dtype=torch.bfloat16) * 0.05)(B, Hkv, C, D)), 'k_tree': _w((lambda *s: torch.randn(*s, dtype=torch.bfloat16) * 0.8)(B, Hkv, T, D)), 'v_tree': _w((lambda *s: torch.randn(*s, dtype=torch.bfloat16) * 0.05)(B, Hkv, T, D)), 'tree_mask': _w(tree_mask)}

def reference(q, k_cache, v_cache, k_tree, v_tree, tree_mask):
    B, Hq, T, D = q.shape
    Hkv, C = (k_cache.shape[1], k_cache.shape[2])
    rep = Hq // Hkv
    kc = (lambda x, n, axis: torch.repeat_interleave(x, n, dim=axis))(k_cache, rep, axis=1)
    vc = (lambda x, n, axis: torch.repeat_interleave(x, n, dim=axis))(v_cache, rep, axis=1)
    kt = (lambda x, n, axis: torch.repeat_interleave(x, n, dim=axis))(k_tree, rep, axis=1)
    vt = (lambda x, n, axis: torch.repeat_interleave(x, n, dim=axis))(v_tree, rep, axis=1)
    k = torch.concatenate([kc, kt], axis=2)
    v = torch.concatenate([vc, vt], axis=2)
    scale = D ** (-0.5)
    scores = torch.einsum('bhqd,bhkd->bhqk', q, k) * scale
    ctx_mask = torch.ones((B, 1, T, C), dtype=scores.dtype)
    tm = tree_mask[:, None, :, :].clone()
    full_mask = torch.concatenate([ctx_mask, tm], axis=-1)
    scores = scores + (1.0 - full_mask) * -1000000000.0
    p = _softmax(scores, axis=-1)
    return torch.einsum('bhqk,bhkd->bhqd', p, v)
```

```asm
; @launch grid=(256,1,1) block=(320,1,1) lds=4608
.amdgcn_target "amdgcn-amd-amdhsa--gfx950"
.text
.globl standalone__tree_speculative_verify_tree_attention_over_candidate_token_tree__decode_kernel
.p2align 8
.type standalone__tree_speculative_verify_tree_attention_over_candidate_token_tree__decode_kernel,@function
standalone__tree_speculative_verify_tree_attention_over_candidate_token_tree__decode_kernel:
    s_load_dwordx16 s[4:19], s[0:1], 0
    s_load_dwordx2 s[20:21], s[0:1], 64
    s_cmp_ge_u32 s2, 256
    s_cbranch_scc1 L_end
    s_and_b32 s22, s2, 15
    s_lshr_b32 s23, s2, 4
    v_and_b32 v1, 63, v0
    v_lshrrev_b32 v2, 6, v0
    s_lshl4_add_u32 s31, s22, s23
    s_lshl_b32 s25, s22, 21
    v_readfirstlane_b32 s24, v2
    s_lshl_b32 s57, s31, 4
    s_cmp_eq_u32 s24, 4
    s_cbranch_scc1 L_stub
    s_bfe_u32 s26, s23, 0x10000
    s_lshl_b32 s26, s26, 15
    s_or_b32 s25, s25, s26
    s_bfe_u32 s26, s23, 0x30001
    s_lshl_b32 s26, s26, 18
    s_or_b32 s25, s25, s26
    v_lshrrev_b32 v4, 4, v1
    v_lshlrev_b32 v4, 6, v4
    v_and_b32 v5, 3, v1
    v_lshl_add_u32 v3, v5, 4, v4
    v_bfe_u32 v6, v1, 2, 2
    v_lshl_add_u32 v6, v6, 8, v3
    s_bfe_u32 s26, s2, 0x20002
    v_xor_b32 v7, s26, v2
    s_bfe_u32 s26, s2, 0x10003
    s_lshl_b32 s26, s26, 12
    s_xor_b32 s25, s25, s26
    s_bfe_u32 s26, s2, 0x10006
    s_lshl_b32 s26, s26, 13
    s_xor_b32 s25, s25, s26
    v_lshl_add_u32 v7, v7, 10, s25
    v_add_u32 v152, v6, v7
    v_lshl_add_u32 v156, v1, 4, v7
    v_xor_b32 v153, 0x2000, v152
    v_xor_b32 v154, 0x1000, v152
    v_xor_b32 v155, 0x3000, v152
    s_mov_b32 s34, 0x2000000
    s_mov_b32 s35, 0x20000
    s_bfe_u32 s26, s2, 0x10004
    s_lshl_b32 s40, s26, 14
    s_xor_b32 s41, s40, 0x4000
    s_xor_b32 s42, s40, 0x10000
    v_bfe_u32 v8, v1, 3, 1
    v_lshl_add_u32 v4, v8, 8, v3
    s_lshl_b32 s26, s22, 9
    v_add_u32 v4, s26, v4
    s_lshl2_add_u32 s56, s31, s24
    s_lshl_b32 s56, s56, 8
    s_waitcnt lgkmcnt(0)
    s_mov_b32 s32, s6
    s_and_b32 s33, s7, 0xffff
    s_load_dwordx2 s[48:49], s[20:21], s56 offset:60
    s_load_dwordx2 s[50:51], s[20:21], s56 offset:188
    s_load_dword s52, s[20:21], s57 offset:0x40000
    buffer_load_dwordx4 v[104:107], v152, s[32:35], s40 offen nt
    global_load_dwordx4 v[20:23], v4, s[4:5]
    s_mov_b32 s28, 0x3e0293ee
    v_lshlrev_b32 v14, 6, v8
    v_lshl_add_u32 v13, v5, 3, v14
    s_mov_b32 s36, s8
    buffer_load_dwordx4 v[108:111], v153, s[32:35], s40 offen nt
    s_and_b32 s37, s9, 0xffff
    s_mov_b32 s38, 0x2000000
    s_mov_b32 s39, 0x20000
    s_xor_b32 s43, s40, 0x14000
    buffer_load_dwordx4 v[112:115], v154, s[32:35], s40 offen nt
    s_xor_b32 s44, s40, 0x20000
    s_xor_b32 s45, s40, 0x24000
    s_xor_b32 s46, s40, 0x30000
    s_xor_b32 s47, s40, 0x34000
    buffer_load_dwordx4 v[116:119], v155, s[32:35], s40 offen nt
    v_xor_b32 v157, 0x2000, v156
    v_xor_b32 v158, 0x1000, v156
    v_xor_b32 v159, 0x3000, v156
    v_lshl_add_u32 v14, v2, 3, v14
    buffer_load_dwordx4 v[120:123], v152, s[32:35], s41 offen nt
    s_lshl_b32 s25, s31, 10
    v_lshl_add_u32 v9, v1, 4, s25
    v_lshlrev_b32 v16, 4, v0
    v_xor_b32 v17, 1024, v16
    buffer_load_dwordx4 v[124:127], v153, s[32:35], s41 offen nt
    v_xor_b32 v18, 2048, v16
    v_xor_b32 v19, 3072, v16
    v_lshlrev_b32 v160, 2, v1
    v_and_b32 v6, 1, v1
    buffer_load_dwordx4 v[128:131], v154, s[32:35], s41 offen nt
    v_lshlrev_b32 v6, 4, v6
    s_mov_b32 s25, 0xffff
    v_lshlrev_b32 v6, v6, s25
    v_bfe_u32 v5, v1, 1, 2
    v_mov_b32 v15, 0
    buffer_load_dwordx4 v[132:135], v155, s[32:35], s41 offen nt
    v_cmp_eq_u32 vcc, 0, v5
    v_mov_b32 v28, 0
    s_nop 0
    v_cndmask_b32 v24, 0, v6, vcc
    buffer_load_dwordx4 v[136:139], v152, s[32:35], s42 offen nt
    v_cmp_eq_u32 vcc, 1, v5
    v_mov_b32 v29, 0
    s_nop 0
    v_cndmask_b32 v25, 0, v6, vcc
    buffer_load_dwordx4 v[140:143], v153, s[32:35], s42 offen nt
    v_cmp_eq_u32 vcc, 2, v5
    v_mov_b32 v30, 0
    s_nop 0
    v_cndmask_b32 v26, 0, v6, vcc
    buffer_load_dwordx4 v[144:147], v154, s[32:35], s42 offen nt
    v_cmp_eq_u32 vcc, 3, v5
    v_mov_b32 v31, 0
    s_nop 0
    v_cndmask_b32 v27, 0, v6, vcc
    buffer_load_dwordx4 v[148:151], v155, s[32:35], s42 offen nt
    s_waitcnt vmcnt(8)
    v_mfma_f32_16x16x32_bf16 v[40:43], v[104:107], v[20:23], 0
    buffer_load_dwordx4 v[104:107], v152, s[32:35], s43 offen nt
    v_mfma_f32_16x16x32_bf16 v[44:47], v[108:111], v[20:23], 0
    buffer_load_dwordx4 v[108:111], v153, s[32:35], s43 offen nt
    v_mfma_f32_16x16x32_bf16 v[48:51], v[112:115], v[20:23], 0
    buffer_load_dwordx4 v[112:115], v154, s[32:35], s43 offen nt
    v_mfma_f32_16x16x32_bf16 v[52:55], v[116:119], v[20:23], 0
    buffer_load_dwordx4 v[116:119], v155, s[32:35], s43 offen nt
    s_waitcnt vmcnt(8)
    v_mfma_f32_16x16x32_bf16 v[56:59], v[120:123], v[20:23], 0
    v_mfma_f32_16x16x32_bf16 v[60:63], v[124:127], v[20:23], 0
    v_mfma_f32_16x16x32_bf16 v[64:67], v[128:131], v[20:23], 0
    v_mfma_f32_16x16x32_bf16 v[68:71], v[132:135], v[20:23], 0
    buffer_load_dwordx4 v[120:123], v152, s[32:35], s44 offen nt
    v_mov_b32_dpp v72, v40 quad_perm:[0,0,0,0] row_mask:0xf bank_mask:0xf
    v_mov_b32_dpp v73, v44 quad_perm:[0,0,0,0] row_mask:0xf bank_mask:0xf
    v_mov_b32_dpp v74, v48 quad_perm:[0,0,0,0] row_mask:0xf bank_mask:0xf
    v_mov_b32_dpp v75, v52 quad_perm:[0,0,0,0] row_mask:0xf bank_mask:0xf
    buffer_load_dwordx4 v[124:127], v153, s[32:35], s44 offen nt
    v_add_f32_dpp v72, v41, v72 quad_perm:[1,1,1,1] row_mask:0xf bank_mask:0xf
    v_add_f32_dpp v73, v45, v73 quad_perm:[1,1,1,1] row_mask:0xf bank_mask:0xf
    v_add_f32_dpp v74, v49, v74 quad_perm:[1,1,1,1] row_mask:0xf bank_mask:0xf
    v_add_f32_dpp v75, v53, v75 quad_perm:[1,1,1,1] row_mask:0xf bank_mask:0xf
    buffer_load_dwordx4 v[128:131], v154, s[32:35], s44 offen nt
    v_add_f32_dpp v72, v42, v72 quad_perm:[2,2,2,2] row_mask:0xf bank_mask:0xf
    v_add_f32_dpp v73, v46, v73 quad_perm:[2,2,2,2] row_mask:0xf bank_mask:0xf
    v_add_f32_dpp v74, v50, v74 quad_perm:[2,2,2,2] row_mask:0xf bank_mask:0xf
    v_add_f32_dpp v75, v54, v75 quad_perm:[2,2,2,2] row_mask:0xf bank_mask:0xf
    buffer_load_dwordx4 v[132:135], v155, s[32:35], s44 offen nt
    v_add_f32_dpp v72, v43, v72 quad_perm:[3,3,3,3] row_mask:0xf bank_mask:0xf
    v_add_f32_dpp v73, v47, v73 quad_perm:[3,3,3,3] row_mask:0xf bank_mask:0xf
    v_add_f32_dpp v74, v51, v74 quad_perm:[3,3,3,3] row_mask:0xf bank_mask:0xf
    v_add_f32_dpp v75, v55, v75 quad_perm:[3,3,3,3] row_mask:0xf bank_mask:0xf
    v_max_f32 v10, v72, v73
    v_max3_f32 v10, v10, v74, v75
    s_waitcnt vmcnt(8)
    v_mfma_f32_16x16x32_bf16 v[40:43], v[136:139], v[20:23], 0
    v_mfma_f32_16x16x32_bf16 v[44:47], v[140:143], v[20:23], 0
    v_mfma_f32_16x16x32_bf16 v[48:51], v[144:147], v[20:23], 0
    v_mfma_f32_16x16x32_bf16 v[52:55], v[148:151], v[20:23], 0
    buffer_load_dwordx4 v[136:139], v152, s[32:35], s45 offen nt
    v_mov_b32_dpp v76, v56 quad_perm:[0,0,0,0] row_mask:0xf bank_mask:0xf
    v_mov_b32_dpp v77, v60 quad_perm:[0,0,0,0] row_mask:0xf bank_mask:0xf
    v_mov_b32_dpp v78, v64 quad_perm:[0,0,0,0] row_mask:0xf bank_mask:0xf
    v_mov_b32_dpp v79, v68 quad_perm:[0,0,0,0] row_mask:0xf bank_mask:0xf
    buffer_load_dwordx4 v[140:143], v153, s[32:35], s45 offen nt
    v_add_f32_dpp v76, v57, v76 quad_perm:[1,1,1,1] row_mask:0xf bank_mask:0xf
    v_add_f32_dpp v77, v61, v77 quad_perm:[1,1,1,1] row_mask:0xf bank_mask:0xf
    v_add_f32_dpp v78, v65, v78 quad_perm:[1,1,1,1] row_mask:0xf bank_mask:0xf
    v_add_f32_dpp v79, v69, v79 quad_perm:[1,1,1,1] row_mask:0xf bank_mask:0xf
    buffer_load_dwordx4 v[144:147], v154, s[32:35], s45 offen nt
    v_add_f32_dpp v76, v58, v76 quad_perm:[2,2,2,2] row_mask:0xf bank_mask:0xf
    v_add_f32_dpp v77, v62, v77 quad_perm:[2,2,2,2] row_mask:0xf bank_mask:0xf
    v_add_f32_dpp v78, v66, v78 quad_perm:[2,2,2,2] row_mask:0xf bank_mask:0xf
    v_add_f32_dpp v79, v70, v79 quad_perm:[2,2,2,2] row_mask:0xf bank_mask:0xf
    buffer_load_dwordx4 v[148:151], v155, s[32:35], s45 offen nt
    v_add_f32_dpp v76, v59, v76 quad_perm:[3,3,3,3] row_mask:0xf bank_mask:0xf
    v_add_f32_dpp v77, v63, v77 quad_perm:[3,3,3,3] row_mask:0xf bank_mask:0xf
    v_add_f32_dpp v78, v67, v78 quad_perm:[3,3,3,3] row_mask:0xf bank_mask:0xf
    v_add_f32_dpp v79, v71, v79 quad_perm:[3,3,3,3] row_mask:0xf bank_mask:0xf
    v_max3_f32 v10, v10, v76, v77
    v_max3_f32 v10, v10, v78, v79
    s_waitcnt vmcnt(8)
    v_mfma_f32_16x16x32_bf16 v[56:59], v[104:107], v[20:23], 0
    v_mfma_f32_16x16x32_bf16 v[60:63], v[108:111], v[20:23], 0
    v_mfma_f32_16x16x32_bf16 v[64:67], v[112:115], v[20:23], 0
    v_mfma_f32_16x16x32_bf16 v[68:71], v[116:119], v[20:23], 0
    buffer_load_dwordx4 v[104:107], v152, s[32:35], s46 offen nt
    v_mov_b32_dpp v80, v40 quad_perm:[0,0,0,0] row_mask:0xf bank_mask:0xf
    v_mov_b32_dpp v81, v44 quad_perm:[0,0,0,0] row_mask:0xf bank_mask:0xf
    v_mov_b32_dpp v82, v48 quad_perm:[0,0,0,0] row_mask:0xf bank_mask:0xf
    v_mov_b32_dpp v83, v52 quad_perm:[0,0,0,0] row_mask:0xf bank_mask:0xf
    buffer_load_dwordx4 v[108:111], v153, s[32:35], s46 offen nt
    v_add_f32_dpp v80, v41, v80 quad_perm:[1,1,1,1] row_mask:0xf bank_mask:0xf
    v_add_f32_dpp v81, v45, v81 quad_perm:[1,1,1,1] row_mask:0xf bank_mask:0xf
    v_add_f32_dpp v82, v49, v82 quad_perm:[1,1,1,1] row_mask:0xf bank_mask:0xf
    v_add_f32_dpp v83, v53, v83 quad_perm:[1,1,1,1] row_mask:0xf bank_mask:0xf
    buffer_load_dwordx4 v[112:115], v154, s[32:35], s46 offen nt
    v_add_f32_dpp v80, v42, v80 quad_perm:[2,2,2,2] row_mask:0xf bank_mask:0xf
    v_add_f32_dpp v81, v46, v81 quad_perm:[2,2,2,2] row_mask:0xf bank_mask:0xf
    v_add_f32_dpp v82, v50, v82 quad_perm:[2,2,2,2] row_mask:0xf bank_mask:0xf
    v_add_f32_dpp v83, v54, v83 quad_perm:[2,2,2,2] row_mask:0xf bank_mask:0xf
    buffer_load_dwordx4 v[116:119], v155, s[32:35], s46 offen nt
    v_add_f32_dpp v80, v43, v80 quad_perm:[3,3,3,3] row_mask:0xf bank_mask:0xf
    v_add_f32_dpp v81, v47, v81 quad_perm:[3,3,3,3] row_mask:0xf bank_mask:0xf
    v_add_f32_dpp v82, v51, v82 quad_perm:[3,3,3,3] row_mask:0xf bank_mask:0xf
    v_add_f32_dpp v83, v55, v83 quad_perm:[3,3,3,3] row_mask:0xf bank_mask:0xf
    v_max3_f32 v10, v10, v80, v81
    v_max3_f32 v10, v10, v82, v83
    s_waitcnt vmcnt(8)
    v_mfma_f32_16x16x32_bf16 v[40:43], v[120:123], v[20:23], 0
    v_mfma_f32_16x16x32_bf16 v[44:47], v[124:127], v[20:23], 0
    v_mfma_f32_16x16x32_bf16 v[48:51], v[128:131], v[20:23], 0
    v_mfma_f32_16x16x32_bf16 v[52:55], v[132:135], v[20:23], 0
    buffer_load_dwordx4 v[120:123], v152, s[32:35], s47 offen nt
    v_mov_b32_dpp v84, v56 quad_perm:[0,0,0,0] row_mask:0xf bank_mask:0xf
    v_mov_b32_dpp v85, v60 quad_perm:[0,0,0,0] row_mask:0xf bank_mask:0xf
    v_mov_b32_dpp v86, v64 quad_perm:[0,0,0,0] row_mask:0xf bank_mask:0xf
    v_mov_b32_dpp v87, v68 quad_perm:[0,0,0,0] row_mask:0xf bank_mask:0xf
    buffer_load_dwordx4 v[124:127], v153, s[32:35], s47 offen nt
    v_add_f32_dpp v84, v57, v84 quad_perm:[1,1,1,1] row_mask:0xf bank_mask:0xf
    v_add_f32_dpp v85, v61, v85 quad_perm:[1,1,1,1] row_mask:0xf bank_mask:0xf
    v_add_f32_dpp v86, v65, v86 quad_perm:[1,1,1,1] row_mask:0xf bank_mask:0xf
    v_add_f32_dpp v87, v69, v87 quad_perm:[1,1,1,1] row_mask:0xf bank_mask:0xf
    buffer_load_dwordx4 v[128:131], v154, s[32:35], s47 offen nt
    v_add_f32_dpp v84, v58, v84 quad_perm:[2,2,2,2] row_mask:0xf bank_mask:0xf
    v_add_f32_dpp v85, v62, v85 quad_perm:[2,2,2,2] row_mask:0xf bank_mask:0xf
    v_add_f32_dpp v86, v66, v86 quad_perm:[2,2,2,2] row_mask:0xf bank_mask:0xf
    v_add_f32_dpp v87, v70, v87 quad_perm:[2,2,2,2] row_mask:0xf bank_mask:0xf
    buffer_load_dwordx4 v[132:135], v155, s[32:35], s47 offen nt
    v_add_f32_dpp v84, v59, v84 quad_perm:[3,3,3,3] row_mask:0xf bank_mask:0xf
    v_add_f32_dpp v85, v63, v85 quad_perm:[3,3,3,3] row_mask:0xf bank_mask:0xf
    v_add_f32_dpp v86, v67, v86 quad_perm:[3,3,3,3] row_mask:0xf bank_mask:0xf
    v_add_f32_dpp v87, v71, v87 quad_perm:[3,3,3,3] row_mask:0xf bank_mask:0xf
    v_max3_f32 v10, v10, v84, v85
    v_max3_f32 v10, v10, v86, v87
    s_waitcnt vmcnt(8)
    v_mfma_f32_16x16x32_bf16 v[56:59], v[136:139], v[20:23], 0
    v_mfma_f32_16x16x32_bf16 v[60:63], v[140:143], v[20:23], 0
    v_mfma_f32_16x16x32_bf16 v[64:67], v[144:147], v[20:23], 0
    v_mfma_f32_16x16x32_bf16 v[68:71], v[148:151], v[20:23], 0
    buffer_load_dwordx4 v[136:139], v156, s[36:39], s40 offen nt
    v_mov_b32_dpp v88, v40 quad_perm:[0,0,0,0] row_mask:0xf bank_mask:0xf
    v_mov_b32_dpp v89, v44 quad_perm:[0,0,0,0] row_mask:0xf bank_mask:0xf
    v_mov_b32_dpp v90, v48 quad_perm:[0,0,0,0] row_mask:0xf bank_mask:0xf
    v_mov_b32_dpp v91, v52 quad_perm:[0,0,0,0] row_mask:0xf bank_mask:0xf
    buffer_load_dwordx4 v[140:143], v157, s[36:39], s40 offen nt
    v_add_f32_dpp v88, v41, v88 quad_perm:[1,1,1,1] row_mask:0xf bank_mask:0xf
    v_add_f32_dpp v89, v45, v89 quad_perm:[1,1,1,1] row_mask:0xf bank_mask:0xf
    v_add_f32_dpp v90, v49, v90 quad_perm:[1,1,1,1] row_mask:0xf bank_mask:0xf
    v_add_f32_dpp v91, v53, v91 quad_perm:[1,1,1,1] row_mask:0xf bank_mask:0xf
    buffer_load_dwordx4 v[144:147], v158, s[36:39], s40 offen nt
    v_add_f32_dpp v88, v42, v88 quad_perm:[2,2,2,2] row_mask:0xf bank_mask:0xf
    v_add_f32_dpp v89, v46, v89 quad_perm:[2,2,2,2] row_mask:0xf bank_mask:0xf
    v_add_f32_dpp v90, v50, v90 quad_perm:[2,2,2,2] row_mask:0xf bank_mask:0xf
    v_add_f32_dpp v91, v54, v91 quad_perm:[2,2,2,2] row_mask:0xf bank_mask:0xf
    buffer_load_dwordx4 v[148:151], v159, s[36:39], s40 offen nt
    v_add_f32_dpp v88, v43, v88 quad_perm:[3,3,3,3] row_mask:0xf bank_mask:0xf
    v_add_f32_dpp v89, v47, v89 quad_perm:[3,3,3,3] row_mask:0xf bank_mask:0xf
    v_add_f32_dpp v90, v51, v90 quad_perm:[3,3,3,3] row_mask:0xf bank_mask:0xf
    v_add_f32_dpp v91, v55, v91 quad_perm:[3,3,3,3] row_mask:0xf bank_mask:0xf
    v_max3_f32 v10, v10, v88, v89
    v_max3_f32 v10, v10, v90, v91
    s_waitcnt vmcnt(8)
    v_mfma_f32_16x16x32_bf16 v[40:43], v[104:107], v[20:23], 0
    v_mfma_f32_16x16x32_bf16 v[44:47], v[108:111], v[20:23], 0
    v_mfma_f32_16x16x32_bf16 v[48:51], v[112:115], v[20:23], 0
    v_mfma_f32_16x16x32_bf16 v[52:55], v[116:119], v[20:23], 0
    buffer_load_dwordx4 v[104:107], v156, s[36:39], s41 offen nt
    v_mov_b32_dpp v92, v56 quad_perm:[0,0,0,0] row_mask:0xf bank_mask:0xf
    v_mov_b32_dpp v93, v60 quad_perm:[0,0,0,0] row_mask:0xf bank_mask:0xf
    v_mov_b32_dpp v94, v64 quad_perm:[0,0,0,0] row_mask:0xf bank_mask:0xf
    v_mov_b32_dpp v95, v68 quad_perm:[0,0,0,0] row_mask:0xf bank_mask:0xf
    buffer_load_dwordx4 v[108:111], v157, s[36:39], s41 offen nt
    v_add_f32_dpp v92, v57, v92 quad_perm:[1,1,1,1] row_mask:0xf bank_mask:0xf
    v_add_f32_dpp v93, v61, v93 quad_perm:[1,1,1,1] row_mask:0xf bank_mask:0xf
    v_add_f32_dpp v94, v65, v94 quad_perm:[1,1,1,1] row_mask:0xf bank_mask:0xf
    v_add_f32_dpp v95, v69, v95 quad_perm:[1,1,1,1] row_mask:0xf bank_mask:0xf
    buffer_load_dwordx4 v[112:115], v158, s[36:39], s41 offen nt
    v_add_f32_dpp v92, v58, v92 quad_perm:[2,2,2,2] row_mask:0xf bank_mask:0xf
    v_add_f32_dpp v93, v62, v93 quad_perm:[2,2,2,2] row_mask:0xf bank_mask:0xf
    v_add_f32_dpp v94, v66, v94 quad_perm:[2,2,2,2] row_mask:0xf bank_mask:0xf
    v_add_f32_dpp v95, v70, v95 quad_perm:[2,2,2,2] row_mask:0xf bank_mask:0xf
    buffer_load_dwordx4 v[116:119], v159, s[36:39], s41 offen nt
    v_add_f32_dpp v92, v59, v92 quad_perm:[3,3,3,3] row_mask:0xf bank_mask:0xf
    v_add_f32_dpp v93, v63, v93 quad_perm:[3,3,3,3] row_mask:0xf bank_mask:0xf
    v_add_f32_dpp v94, v67, v94 quad_perm:[3,3,3,3] row_mask:0xf bank_mask:0xf
    v_add_f32_dpp v95, v71, v95 quad_perm:[3,3,3,3] row_mask:0xf bank_mask:0xf
    v_max3_f32 v10, v10, v92, v93
    v_max3_f32 v10, v10, v94, v95
    s_waitcnt vmcnt(8)
    v_mfma_f32_16x16x32_bf16 v[56:59], v[120:123], v[20:23], 0
    v_mfma_f32_16x16x32_bf16 v[60:63], v[124:127], v[20:23], 0
    v_mfma_f32_16x16x32_bf16 v[64:67], v[128:131], v[20:23], 0
    v_mfma_f32_16x16x32_bf16 v[68:71], v[132:135], v[20:23], 0
    buffer_load_dwordx4 v[120:123], v156, s[36:39], s42 offen nt
    v_mov_b32_dpp v96, v40 quad_perm:[0,0,0,0] row_mask:0xf bank_mask:0xf
    v_mov_b32_dpp v97, v44 quad_perm:[0,0,0,0] row_mask:0xf bank_mask:0xf
    v_mov_b32_dpp v98, v48 quad_perm:[0,0,0,0] row_mask:0xf bank_mask:0xf
    v_mov_b32_dpp v99, v52 quad_perm:[0,0,0,0] row_mask:0xf bank_mask:0xf
    buffer_load_dwordx4 v[124:127], v157, s[36:39], s42 offen nt
    v_add_f32_dpp v96, v41, v96 quad_perm:[1,1,1,1] row_mask:0xf bank_mask:0xf
    v_add_f32_dpp v97, v45, v97 quad_perm:[1,1,1,1] row_mask:0xf bank_mask:0xf
    v_add_f32_dpp v98, v49, v98 quad_perm:[1,1,1,1] row_mask:0xf bank_mask:0xf
    v_add_f32_dpp v99, v53, v99 quad_perm:[1,1,1,1] row_mask:0xf bank_mask:0xf
    buffer_load_dwordx4 v[128:131], v158, s[36:39], s42 offen nt
    v_add_f32_dpp v96, v42, v96 quad_perm:[2,2,2,2] row_mask:0xf bank_mask:0xf
    v_add_f32_dpp v97, v46, v97 quad_perm:[2,2,2,2] row_mask:0xf bank_mask:0xf
    v_add_f32_dpp v98, v50, v98 quad_perm:[2,2,2,2] row_mask:0xf bank_mask:0xf
    v_add_f32_dpp v99, v54, v99 quad_perm:[2,2,2,2] row_mask:0xf bank_mask:0xf
    buffer_load_dwordx4 v[132:135], v159, s[36:39], s42 offen nt
    v_add_f32_dpp v96, v43, v96 quad_perm:[3,3,3,3] row_mask:0xf bank_mask:0xf
    v_add_f32_dpp v97, v47, v97 quad_perm:[3,3,3,3] row_mask:0xf bank_mask:0xf
    v_add_f32_dpp v98, v51, v98 quad_perm:[3,3,3,3] row_mask:0xf bank_mask:0xf
    v_add_f32_dpp v99, v55, v99 quad_perm:[3,3,3,3] row_mask:0xf bank_mask:0xf
    v_max3_f32 v10, v10, v96, v97
    v_max3_f32 v10, v10, v98, v99
    v_mov_b32_dpp v100, v56 quad_perm:[0,0,0,0] row_mask:0xf bank_mask:0xf
    v_mov_b32_dpp v101, v60 quad_perm:[0,0,0,0] row_mask:0xf bank_mask:0xf
    v_mov_b32_dpp v102, v64 quad_perm:[0,0,0,0] row_mask:0xf bank_mask:0xf
    v_mov_b32_dpp v103, v68 quad_perm:[0,0,0,0] row_mask:0xf bank_mask:0xf
    v_add_f32_dpp v100, v57, v100 quad_perm:[1,1,1,1] row_mask:0xf bank_mask:0xf
    v_add_f32_dpp v101, v61, v101 quad_perm:[1,1,1,1] row_mask:0xf bank_mask:0xf
    v_add_f32_dpp v102, v65, v102 quad_perm:[1,1,1,1] row_mask:0xf bank_mask:0xf
    v_add_f32_dpp v103, v69, v103 quad_perm:[1,1,1,1] row_mask:0xf bank_mask:0xf
    v_add_f32_dpp v100, v58, v100 quad_perm:[2,2,2,2] row_mask:0xf bank_mask:0xf
    v_add_f32_dpp v101, v62, v101 quad_perm:[2,2,2,2] row_mask:0xf bank_mask:0xf
    v_add_f32_dpp v102, v66, v102 quad_perm:[2,2,2,2] row_mask:0xf bank_mask:0xf
    v_add_f32_dpp v103, v70, v103 quad_perm:[2,2,2,2] row_mask:0xf bank_mask:0xf
    v_add_f32_dpp v100, v59, v100 quad_perm:[3,3,3,3] row_mask:0xf bank_mask:0xf
    v_add_f32_dpp v101, v63, v101 quad_perm:[3,3,3,3] row_mask:0xf bank_mask:0xf
    v_add_f32_dpp v102, v67, v102 quad_perm:[3,3,3,3] row_mask:0xf bank_mask:0xf
    v_add_f32_dpp v103, v71, v103 quad_perm:[3,3,3,3] row_mask:0xf bank_mask:0xf
    v_max3_f32 v10, v10, v100, v101
    v_max3_f32 v10, v10, v102, v103
    v_mov_b32 v4, v10
    s_nop 1
    v_permlane16_swap_b32 v10, v4
    v_max_f32 v10, v10, v4
    v_mov_b32 v4, v10
    s_nop 1
    v_permlane32_swap_b32 v10, v4
    v_max_f32 v10, v10, v4
    v_mul_f32 v10, s28, v10
    v_and_b32 v10, -2, v10
    v_pk_fma_f32 v[72:73], v[72:73], s[28:29], v[10:11] op_sel_hi:[1,0,0] neg_lo:[0,0,1] neg_hi:[0,0,1]
    v_pk_fma_f32 v[74:75], v[74:75], s[28:29], v[10:11] op_sel_hi:[1,0,0] neg_lo:[0,0,1] neg_hi:[0,0,1]
    v_pk_fma_f32 v[76:77], v[76:77], s[28:29], v[10:11] op_sel_hi:[1,0,0] neg_lo:[0,0,1] neg_hi:[0,0,1]
    v_pk_fma_f32 v[78:79], v[78:79], s[28:29], v[10:11] op_sel_hi:[1,0,0] neg_lo:[0,0,1] neg_hi:[0,0,1]
    v_pk_fma_f32 v[80:81], v[80:81], s[28:29], v[10:11] op_sel_hi:[1,0,0] neg_lo:[0,0,1] neg_hi:[0,0,1]
    v_pk_fma_f32 v[82:83], v[82:83], s[28:29], v[10:11] op_sel_hi:[1,0,0] neg_lo:[0,0,1] neg_hi:[0,0,1]
    v_pk_fma_f32 v[84:85], v[84:85], s[28:29], v[10:11] op_sel_hi:[1,0,0] neg_lo:[0,0,1] neg_hi:[0,0,1]
    v_pk_fma_f32 v[86:87], v[86:87], s[28:29], v[10:11] op_sel_hi:[1,0,0] neg_lo:[0,0,1] neg_hi:[0,0,1]
    v_pk_fma_f32 v[88:89], v[88:89], s[28:29], v[10:11] op_sel_hi:[1,0,0] neg_lo:[0,0,1] neg_hi:[0,0,1]
    v_pk_fma_f32 v[90:91], v[90:91], s[28:29], v[10:11] op_sel_hi:[1,0,0] neg_lo:[0,0,1] neg_hi:[0,0,1]
    v_pk_fma_f32 v[92:93], v[92:93], s[28:29], v[10:11] op_sel_hi:[1,0,0] neg_lo:[0,0,1] neg_hi:[0,0,1]
    v_pk_fma_f32 v[94:95], v[94:95], s[28:29], v[10:11] op_sel_hi:[1,0,0] neg_lo:[0,0,1] neg_hi:[0,0,1]
    v_pk_fma_f32 v[96:97], v[96:97], s[28:29], v[10:11] op_sel_hi:[1,0,0] neg_lo:[0,0,1] neg_hi:[0,0,1]
    v_pk_fma_f32 v[98:99], v[98:99], s[28:29], v[10:11] op_sel_hi:[1,0,0] neg_lo:[0,0,1] neg_hi:[0,0,1]
    v_pk_fma_f32 v[100:101], v[100:101], s[28:29], v[10:11] op_sel_hi:[1,0,0] neg_lo:[0,0,1] neg_hi:[0,0,1]
    v_pk_fma_f32 v[102:103], v[102:103], s[28:29], v[10:11] op_sel_hi:[1,0,0] neg_lo:[0,0,1] neg_hi:[0,0,1]
    s_branch L_page2
    .p2align 12
L_stub:
    s_branch L_helper
L_page2:
    v_exp_f32 v72, v72
    v_exp_f32 v73, v73
    v_exp_f32 v74, v74
    v_exp_f32 v75, v75
    v_exp_f32 v76, v76
    v_exp_f32 v77, v77
    v_exp_f32 v78, v78
    v_exp_f32 v79, v79
    v_exp_f32 v80, v80
    v_exp_f32 v81, v81
    v_exp_f32 v82, v82
    v_exp_f32 v83, v83
    v_exp_f32 v84, v84
    v_exp_f32 v85, v85
    v_exp_f32 v86, v86
    v_exp_f32 v87, v87
    v_exp_f32 v88, v88
    v_exp_f32 v89, v89
    v_exp_f32 v90, v90
    v_exp_f32 v91, v91
    v_exp_f32 v92, v92
    v_exp_f32 v93, v93
    v_exp_f32 v94, v94
    v_exp_f32 v95, v95
    v_exp_f32 v96, v96
    v_exp_f32 v97, v97
    v_exp_f32 v98, v98
    v_exp_f32 v99, v99
    v_exp_f32 v100, v100
    v_exp_f32 v101, v101
    v_exp_f32 v102, v102
    v_exp_f32 v103, v103
    v_pk_add_f32 v[6:7], v[72:73], v[74:75]
    v_pk_add_f32 v[6:7], v[6:7], v[76:77]
    v_pk_add_f32 v[6:7], v[6:7], v[78:79]
    v_pk_add_f32 v[6:7], v[6:7], v[80:81]
    v_pk_add_f32 v[6:7], v[6:7], v[82:83]
    v_pk_add_f32 v[6:7], v[6:7], v[84:85]
    v_pk_add_f32 v[6:7], v[6:7], v[86:87]
    v_pk_add_f32 v[6:7], v[6:7], v[88:89]
    v_pk_add_f32 v[6:7], v[6:7], v[90:91]
    v_pk_add_f32 v[6:7], v[6:7], v[92:93]
    v_pk_add_f32 v[6:7], v[6:7], v[94:95]
    v_pk_add_f32 v[6:7], v[6:7], v[96:97]
    v_pk_add_f32 v[6:7], v[6:7], v[98:99]
    v_pk_add_f32 v[6:7], v[6:7], v[100:101]
    v_pk_add_f32 v[6:7], v[6:7], v[102:103]
    v_add_f32 v11, v6, v7
    v_mov_b32 v4, v11
    s_nop 1
    v_permlane16_swap_b32 v11, v4
    v_add_f32 v11, v11, v4
    v_mov_b32 v4, v11
    s_nop 1
    v_permlane32_swap_b32 v11, v4
    v_add_f32 v11, v11, v4
    ds_write_b64 v14, v[10:11] offset:0
    s_waitcnt lgkmcnt(0)
    s_barrier
    ds_read_b32 v12, v13 offset:0
    s_waitcnt lgkmcnt(0)
    v_max_f32_dpp v12, v12, v12 quad_perm:[1,0,3,2] row_mask:0xf bank_mask:0xf
    s_nop 1
    v_max_f32_dpp v12, v12, v12 quad_perm:[2,3,0,1] row_mask:0xf bank_mask:0xf
    v_sub_f32 v12, v10, v12
    v_exp_f32 v12, v12
    v_mov_b32 v5, 1
    v_mul_f32 v72, v12, v72
    v_cvt_pk_bf16_f32 v72, v72, v72
    v_and_b32 v32, v24, v72
    v_and_b32 v33, v25, v72
    v_and_b32 v34, v26, v72
    v_and_b32 v35, v27, v72
    s_nop 0
    s_waitcnt vmcnt(11)
    v_mfma_f32_16x16x32_bf16 v[28:31], v[32:35], v[136:139], v[28:31]
    v_mul_f32 v73, v12, v73
    v_cvt_pk_bf16_f32 v73, v73, v73
    v_and_b32 v36, v24, v73
    v_and_b32 v37, v25, v73
    v_and_b32 v38, v26, v73
    v_and_b32 v39, v27, v73
    buffer_load_dwordx4 v[136:139], v156, s[36:39], s43 offen nt
    s_waitcnt vmcnt(11)
    v_mfma_f32_16x16x32_bf16 v[28:31], v[36:39], v[140:143], v[28:31]
    v_mul_f32 v74, v12, v74
    v_cvt_pk_bf16_f32 v74, v74, v74
    v_and_b32 v32, v24, v74
    v_and_b32 v33, v25, v74
    v_and_b32 v34, v26, v74
    v_and_b32 v35, v27, v74
    buffer_load_dwordx4 v[140:143], v157, s[36:39], s43 offen nt
    s_waitcnt vmcnt(11)
    v_mfma_f32_16x16x32_bf16 v[28:31], v[32:35], v[144:147], v[28:31]
    v_mul_f32 v75, v12, v75
    v_cvt_pk_bf16_f32 v75, v75, v75
    v_and_b32 v36, v24, v75
    v_and_b32 v37, v25, v75
    v_and_b32 v38, v26, v75
    v_and_b32 v39, v27, v75
    buffer_load_dwordx4 v[144:147], v158, s[36:39], s43 offen nt
    s_waitcnt vmcnt(11)
    v_mfma_f32_16x16x32_bf16 v[28:31], v[36:39], v[148:151], v[28:31]
    v_mul_f32 v76, v12, v76
    v_cvt_pk_bf16_f32 v76, v76, v76
    v_and_b32 v32, v24, v76
    v_and_b32 v33, v25, v76
    v_and_b32 v34, v26, v76
    v_and_b32 v35, v27, v76
    buffer_load_dwordx4 v[148:151], v159, s[36:39], s43 offen nt
    s_waitcnt vmcnt(11)
    v_mfma_f32_16x16x32_bf16 v[28:31], v[32:35], v[104:107], v[28:31]
    v_mul_f32 v77, v12, v77
    v_cvt_pk_bf16_f32 v77, v77, v77
    v_and_b32 v36, v24, v77
    v_and_b32 v37, v25, v77
    v_and_b32 v38, v26, v77
    v_and_b32 v39, v27, v77
    buffer_load_dwordx4 v[104:107], v156, s[36:39], s44 offen nt
    s_waitcnt vmcnt(11)
    v_mfma_f32_16x16x32_bf16 v[28:31], v[36:39], v[108:111], v[28:31]
    v_mul_f32 v78, v12, v78
    v_cvt_pk_bf16_f32 v78, v78, v78
    v_and_b32 v32, v24, v78
    v_and_b32 v33, v25, v78
    v_and_b32 v34, v26, v78
    v_and_b32 v35, v27, v78
    buffer_load_dwordx4 v[108:111], v157, s[36:39], s44 offen nt
    s_waitcnt vmcnt(11)
    v_mfma_f32_16x16x32_bf16 v[28:31], v[32:35], v[112:115], v[28:31]
    v_mul_f32 v79, v12, v79
    v_cvt_pk_bf16_f32 v79, v79, v79
    v_and_b32 v36, v24, v79
    v_and_b32 v37, v25, v79
    v_and_b32 v38, v26, v79
    v_and_b32 v39, v27, v79
    buffer_load_dwordx4 v[112:115], v158, s[36:39], s44 offen nt
    s_waitcnt vmcnt(11)
    v_mfma_f32_16x16x32_bf16 v[28:31], v[36:39], v[116:119], v[28:31]
    v_mul_f32 v80, v12, v80
    v_cvt_pk_bf16_f32 v80, v80, v80
    v_and_b32 v32, v24, v80
    v_and_b32 v33, v25, v80
    v_and_b32 v34, v26, v80
    v_and_b32 v35, v27, v80
    buffer_load_dwordx4 v[116:119], v159, s[36:39], s44 offen nt
    s_waitcnt vmcnt(11)
    v_mfma_f32_16x16x32_bf16 v[28:31], v[32:35], v[120:123], v[28:31]
    v_mul_f32 v81, v12, v81
    v_cvt_pk_bf16_f32 v81, v81, v81
    v_and_b32 v36, v24, v81
    v_and_b32 v37, v25, v81
    v_and_b32 v38, v26, v81
    v_and_b32 v39, v27, v81
    buffer_load_dwordx4 v[120:123], v156, s[36:39], s45 offen nt
    s_waitcnt vmcnt(11)
    v_mfma_f32_16x16x32_bf16 v[28:31], v[36:39], v[124:127], v[28:31]
    v_mul_f32 v82, v12, v82
    v_cvt_pk_bf16_f32 v82, v82, v82
    v_and_b32 v32, v24, v82
    v_and_b32 v33, v25, v82
    v_and_b32 v34, v26, v82
    v_and_b32 v35, v27, v82
    buffer_load_dwordx4 v[124:127], v157, s[36:39], s45 offen nt
    s_waitcnt vmcnt(11)
    v_mfma_f32_16x16x32_bf16 v[28:31], v[32:35], v[128:131], v[28:31]
    v_mul_f32 v83, v12, v83
    v_cvt_pk_bf16_f32 v83, v83, v83
    v_and_b32 v36, v24, v83
    v_and_b32 v37, v25, v83
    v_and_b32 v38, v26, v83
    v_and_b32 v39, v27, v83
    buffer_load_dwordx4 v[128:131], v158, s[36:39], s45 offen nt
    s_waitcnt vmcnt(11)
    v_mfma_f32_16x16x32_bf16 v[28:31], v[36:39], v[132:135], v[28:31]
    v_mul_f32 v84, v12, v84
    v_cvt_pk_bf16_f32 v84, v84, v84
    v_and_b32 v32, v24, v84
    v_and_b32 v33, v25, v84
    v_and_b32 v34, v26, v84
    v_and_b32 v35, v27, v84
    buffer_load_dwordx4 v[132:135], v159, s[36:39], s45 offen nt
    s_waitcnt vmcnt(11)
    v_mfma_f32_16x16x32_bf16 v[28:31], v[32:35], v[136:139], v[28:31]
    v_mul_f32 v85, v12, v85
    v_cvt_pk_bf16_f32 v85, v85, v85
    v_and_b32 v36, v24, v85
    v_and_b32 v37, v25, v85
    v_and_b32 v38, v26, v85
    v_and_b32 v39, v27, v85
    buffer_load_dwordx4 v[136:139], v156, s[36:39], s46 offen nt
    s_waitcnt vmcnt(11)
    v_mfma_f32_16x16x32_bf16 v[28:31], v[36:39], v[140:143], v[28:31]
    v_mul_f32 v86, v12, v86
    v_cvt_pk_bf16_f32 v86, v86, v86
    v_and_b32 v32, v24, v86
    v_and_b32 v33, v25, v86
    v_and_b32 v34, v26, v86
    v_and_b32 v35, v27, v86
    buffer_load_dwordx4 v[140:143], v157, s[36:39], s46 offen nt
    s_waitcnt vmcnt(11)
    v_mfma_f32_16x16x32_bf16 v[28:31], v[32:35], v[144:147], v[28:31]
    v_mul_f32 v87, v12, v87
    v_cvt_pk_bf16_f32 v87, v87, v87
    v_and_b32 v36, v24, v87
    v_and_b32 v37, v25, v87
    v_and_b32 v38, v26, v87
    v_and_b32 v39, v27, v87
    buffer_load_dwordx4 v[144:147], v158, s[36:39], s46 offen nt
    s_waitcnt vmcnt(11)
    v_mfma_f32_16x16x32_bf16 v[28:31], v[36:39], v[148:151], v[28:31]
    v_mul_f32 v88, v12, v88
    v_cvt_pk_bf16_f32 v88, v88, v88
    v_and_b32 v32, v24, v88
    v_and_b32 v33, v25, v88
    v_and_b32 v34, v26, v88
    v_and_b32 v35, v27, v88
    buffer_load_dwordx4 v[148:151], v159, s[36:39], s46 offen nt
    s_waitcnt vmcnt(11)
    v_mfma_f32_16x16x32_bf16 v[28:31], v[32:35], v[104:107], v[28:31]
    v_mul_f32 v89, v12, v89
    v_cvt_pk_bf16_f32 v89, v89, v89
    v_and_b32 v36, v24, v89
    v_and_b32 v37, v25, v89
    v_and_b32 v38, v26, v89
    v_and_b32 v39, v27, v89
    buffer_load_dwordx4 v[104:107], v156, s[36:39], s47 offen nt
    s_waitcnt vmcnt(11)
    v_mfma_f32_16x16x32_bf16 v[28:31], v[36:39], v[108:111], v[28:31]
    v_mul_f32 v90, v12, v90
    v_cvt_pk_bf16_f32 v90, v90, v90
    v_and_b32 v32, v24, v90
    v_and_b32 v33, v25, v90
    v_and_b32 v34, v26, v90
    v_and_b32 v35, v27, v90
    buffer_load_dwordx4 v[108:111], v157, s[36:39], s47 offen nt
    s_waitcnt vmcnt(11)
    v_mfma_f32_16x16x32_bf16 v[28:31], v[32:35], v[112:115], v[28:31]
    v_mul_f32 v91, v12, v91
    v_cvt_pk_bf16_f32 v91, v91, v91
    v_and_b32 v36, v24, v91
    v_and_b32 v37, v25, v91
    v_and_b32 v38, v26, v91
    v_and_b32 v39, v27, v91
    buffer_load_dwordx4 v[112:115], v158, s[36:39], s47 offen nt
    s_waitcnt vmcnt(11)
    v_mfma_f32_16x16x32_bf16 v[28:31], v[36:39], v[116:119], v[28:31]
    v_mul_f32 v92, v12, v92
    v_cvt_pk_bf16_f32 v92, v92, v92
    v_and_b32 v32, v24, v92
    v_and_b32 v33, v25, v92
    v_and_b32 v34, v26, v92
    v_and_b32 v35, v27, v92
    buffer_load_dwordx4 v[116:119], v159, s[36:39], s47 offen nt
    s_waitcnt vmcnt(11)
    v_mfma_f32_16x16x32_bf16 v[28:31], v[32:35], v[120:123], v[28:31]
    v_mul_f32 v93, v12, v93
    v_cvt_pk_bf16_f32 v93, v93, v93
    v_and_b32 v36, v24, v93
    v_and_b32 v37, v25, v93
    v_and_b32 v38, v26, v93
    v_and_b32 v39, v27, v93
    s_nop 0
    s_waitcnt vmcnt(10)
    v_mfma_f32_16x16x32_bf16 v[28:31], v[36:39], v[124:127], v[28:31]
    v_mul_f32 v94, v12, v94
    v_cvt_pk_bf16_f32 v94, v94, v94
    v_and_b32 v32, v24, v94
    v_and_b32 v33, v25, v94
    v_and_b32 v34, v26, v94
    v_and_b32 v35, v27, v94
    s_nop 0
    s_waitcnt vmcnt(9)
    v_mfma_f32_16x16x32_bf16 v[28:31], v[32:35], v[128:131], v[28:31]
    v_mul_f32 v95, v12, v95
    v_cvt_pk_bf16_f32 v95, v95, v95
    v_and_b32 v36, v24, v95
    v_and_b32 v37, v25, v95
    v_and_b32 v38, v26, v95
    v_and_b32 v39, v27, v95
    s_nop 0
    s_waitcnt vmcnt(8)
    v_mfma_f32_16x16x32_bf16 v[28:31], v[36:39], v[132:135], v[28:31]
    v_mul_f32 v96, v12, v96
    v_cvt_pk_bf16_f32 v96, v96, v96
    v_and_b32 v32, v24, v96
    v_and_b32 v33, v25, v96
    v_and_b32 v34, v26, v96
    v_and_b32 v35, v27, v96
    s_nop 0
    s_waitcnt vmcnt(7)
    v_mfma_f32_16x16x32_bf16 v[28:31], v[32:35], v[136:139], v[28:31]
    v_mul_f32 v97, v12, v97
    v_cvt_pk_bf16_f32 v97, v97, v97
    v_and_b32 v36, v24, v97
    v_and_b32 v37, v25, v97
    v_and_b32 v38, v26, v97
    v_and_b32 v39, v27, v97
    v_mul_f32 v100, v12, v100
    v_cvt_pk_bf16_f32 v100, v100, v100
    v_and_b32 v40, v24, v100
    v_and_b32 v41, v25, v100
    v_and_b32 v42, v26, v100
    v_and_b32 v43, v27, v100
    s_waitcnt vmcnt(6)
    v_mfma_f32_16x16x32_bf16 v[28:31], v[36:39], v[140:143], v[28:31]
    v_mul_f32 v98, v12, v98
    v_cvt_pk_bf16_f32 v98, v98, v98
    v_and_b32 v32, v24, v98
    v_and_b32 v33, v25, v98
    v_and_b32 v34, v26, v98
    v_and_b32 v35, v27, v98
    v_mul_f32 v101, v12, v101
    v_cvt_pk_bf16_f32 v101, v101, v101
    v_and_b32 v44, v24, v101
    v_and_b32 v45, v25, v101
    v_and_b32 v46, v26, v101
    v_and_b32 v47, v27, v101
    s_waitcnt vmcnt(5)
    v_mfma_f32_16x16x32_bf16 v[28:31], v[32:35], v[144:147], v[28:31]
    v_mul_f32 v99, v12, v99
    v_cvt_pk_bf16_f32 v99, v99, v99
    v_and_b32 v36, v24, v99
    v_and_b32 v37, v25, v99
    v_and_b32 v38, v26, v99
    v_and_b32 v39, v27, v99
    v_mul_f32 v102, v12, v102
    v_cvt_pk_bf16_f32 v102, v102, v102
    v_and_b32 v48, v24, v102
    v_and_b32 v49, v25, v102
    v_and_b32 v50, v26, v102
    v_and_b32 v51, v27, v102
    s_waitcnt vmcnt(4)
    v_mfma_f32_16x16x32_bf16 v[28:31], v[36:39], v[148:151], v[28:31]
    v_mul_f32 v103, v12, v103
    v_cvt_pk_bf16_f32 v103, v103, v103
    v_and_b32 v52, v24, v103
    v_and_b32 v53, v25, v103
    v_and_b32 v54, v26, v103
    v_and_b32 v55, v27, v103
    s_setprio 3
    s_waitcnt vmcnt(3)
    v_mfma_f32_16x16x32_bf16 v[28:31], v[40:43], v[104:107], v[28:31]
    s_waitcnt vmcnt(2)
    v_mfma_f32_16x16x32_bf16 v[28:31], v[44:47], v[108:111], v[28:31]
    s_waitcnt vmcnt(1)
    v_mfma_f32_16x16x32_bf16 v[28:31], v[48:51], v[112:115], v[28:31]
    s_waitcnt vmcnt(0)
    v_mfma_f32_16x16x32_bf16 v[28:31], v[52:55], v[116:119], v[28:31]
    s_nop 7
    ds_write_b128 v16, v[28:31] offset:512
    ds_add_rtn_u32 v4, v160, v5 offset:256
    ds_read_b128 v[104:107], v17 offset:512
    ds_read_b128 v[108:111], v18 offset:512
    ds_read_b128 v[112:115], v19 offset:512
    s_waitcnt lgkmcnt(3)
    v_cmp_eq_u32 vcc, 3, v4
    s_waitcnt lgkmcnt(2)
    v_pk_add_f32 v[28:29], v[28:29], v[104:105]
    v_pk_add_f32 v[30:31], v[30:31], v[106:107]
    s_and_b64 exec, exec, vcc
    s_cbranch_scc0 L_join
    s_waitcnt lgkmcnt(0)
    v_pk_add_f32 v[108:109], v[108:109], v[112:113]
    v_pk_add_f32 v[110:111], v[110:111], v[114:115]
    v_pk_add_f32 v[28:29], v[28:29], v[108:109]
    v_pk_add_f32 v[30:31], v[30:31], v[110:111]
    v_and_b32 v28, -2, v28
    v_and_b32 v29, -2, v29
    v_and_b32 v30, -2, v30
    v_and_b32 v31, -2, v31
    global_store_dwordx4 v9, v[28:31], s[20:21]
L_join:
    s_barrier
    s_mov_b64 s[54:55], exec
    s_mov_b64 exec, -1
    ds_read_b32 v15, v15 offset:128
    s_waitcnt lgkmcnt(0)
    v_cmp_ne_u32 vcc, 0, v15
    s_cbranch_vccnz L_through
L_end:
    s_endpgm
L_through:
    v_add_u32 v9, 0x80000, v9
    s_and_b64 exec, exec, s[54:55]
    s_cbranch_scc0 L_through1
    global_store_dwordx4 v9, v[28:31], s[20:21] sc1
    s_waitcnt vmcnt(0)
L_through1:
    s_barrier
    s_endpgm
    .p2align 5
    .fill 5, 4, 0xbf800000
L_helper:
    v_lshrrev_b32 v4, 4, v1
    v_lshlrev_b32 v4, 6, v4
    v_and_b32 v5, 3, v1
    v_lshl_add_u32 v3, v5, 4, v4
    v_bfe_u32 v8, v1, 3, 1
    v_lshl_add_u32 v4, v8, 8, v3
    s_lshl_b32 s26, s22, 9
    v_add_u32 v4, s26, v4
    s_mov_b32 s28, 0x3e0293ee
    v_lshlrev_b32 v14, 6, v8
    v_lshl_add_u32 v13, v5, 3, v14
    s_getreg_b32 s61, hwreg(HW_REG_XCC_ID, 0, 4)
    s_add_u32 s61, s61, 1
    s_lshl_b32 s25, s22, 4
    v_mov_b32 v67, s25
    s_add_u32 s57, s57, 0x40000
    v_lshl_add_u32 v73, v8, 3, s57
    s_lshl_b32 s25, s31, 10
    v_lshl_add_u32 v65, v1, 4, s25
    s_lshl_b32 s56, s22, 8
    v_add_u32 v44, s56, v3
    s_add_u32 s26, s56, 0x40000
    v_lshl_add_u32 v66, v1, 4, s26
    v_mov_b32 v32, -1
    v_mov_b32 v33, -1
    v_mov_b32 v34, -1
    v_mov_b32 v35, -1
    v_lshrrev_b32 v68, 2, v1
    s_mov_b32 s63, s23
    s_mov_b32 s62, 0
    s_lshl_b32 s25, s22, 14
    s_lshl_b32 s26, s63, 6
    s_add_u32 s25, s25, s26
    v_and_b32 v5, 3, v1
    v_lshl_add_u32 v69, v68, 10, s25
    v_lshl_add_u32 v69, v5, 4, v69
    s_lshl_b32 s25, s22, 8
    s_and_b32 s26, s63, 8
    s_add_u32 s25, s25, s26
    s_add_u32 s25, s25, 0x40000
    v_lshl_add_u32 v70, v68, 4, s25
    s_and_b32 s25, s63, 3
    s_lshl_b32 s25, s25, 5
    s_and_b32 s30, s63, 4
    s_add_u32 s25, s25, s30
    s_lshl_b32 s30, s22, 7
    s_add_u32 s25, s25, s30
    v_lshl_add_u32 v5, v5, 3, s25
    v_lshlrev_b32 v74, 1, v5
    s_lshl4_add_u32 s30, s26, s30
    v_lshrrev_b32 v6, 4, v1
    v_add3_u32 v5, v5, v6, s30
    v_lshlrev_b32 v71, 1, v5
    s_cmp_lg_u32 s23, 0
    s_waitcnt lgkmcnt(0)
    s_load_dwordx2 s[48:49], s[10:11], s56 offset:60
    s_load_dwordx2 s[48:49], s[10:11], s56 offset:188
    s_load_dwordx2 s[48:49], s[12:13], s56 offset:60
    s_load_dwordx2 s[48:49], s[12:13], s56 offset:188
    s_load_dword s50, s[14:15], 0
    s_cbranch_scc1 L_h0
    s_mov_b64 exec, 0xffff
    global_store_dwordx4 v66, v[32:35], s[20:21]
    s_mov_b64 exec, -1
L_h0:
    global_store_dwordx4 v65, v[32:35], s[20:21]
    v_mov_b32 v12, s61
    s_waitcnt vmcnt(0)
    s_cbranch_scc1 L_h1
    s_mov_b64 exec, 1
    global_store_dword v67, v12, s[18:19] sc1
    s_mov_b64 exec, -1
L_h1:
    s_waitcnt lgkmcnt(0)
    global_load_dwordx4 v[20:23], v4, s[4:5]
    global_load_dwordx4 v[44:47], v44, s[10:11]
    global_load_dwordx2 v[48:49], v74, s[12:13]
    s_waitcnt vmcnt(0)
    v_mfma_f32_16x16x32_bf16 v[40:43], v[44:47], v[20:23], 0
    v_lshlrev_b32 v5, 2, v1
    v_mov_b32 v6, 0
    ds_write_b32 v5, v6 offset:256
    s_lshl_b32 s26, s14, 3
    s_lshr_b32 s26, s50, s26
    s_lshl_b32 s26, s26, 16
    v_sub_f32 v64, 1.0, s26
    s_mov_b32 s25, 0xd028965f
    v_mov_b32_dpp v10, v40 quad_perm:[0,0,0,0] row_mask:0xf bank_mask:0xf
    s_nop 1
    v_add_f32_dpp v10, v41, v10 quad_perm:[1,1,1,1] row_mask:0xf bank_mask:0xf
    s_nop 1
    v_add_f32_dpp v10, v42, v10 quad_perm:[2,2,2,2] row_mask:0xf bank_mask:0xf
    s_nop 1
    v_add_f32_dpp v10, v43, v10 quad_perm:[3,3,3,3] row_mask:0xf bank_mask:0xf
    v_fma_f32 v10, v64, s25, v10
    v_mul_f32 v10, s28, v10
    s_waitcnt lgkmcnt(0)
    v_readlane_b32 s58, v10, 0
    v_readlane_b32 s59, v10, 8
    s_barrier
    global_load_dword v12, v67, s[18:19] sc1
    ds_read_b64 v[40:41], v13 offset:0
    s_mov_b32 s29, 64
    s_waitcnt lgkmcnt(0)
    v_max_f32_dpp v10, v40, v40 quad_perm:[1,0,3,2] row_mask:0xf bank_mask:0xf
    s_nop 1
    v_max_f32_dpp v10, v10, v10 quad_perm:[2,3,0,1] row_mask:0xf bank_mask:0xf
    v_sub_f32 v40, v40, v10
    v_exp_f32 v40, v40
    s_nop 0
    v_mul_f32 v11, v40, v41
    s_nop 1
    v_add_f32_dpp v11, v11, v11 quad_perm:[1,0,3,2] row_mask:0xf bank_mask:0xf
    s_nop 1
    v_add_f32_dpp v11, v11, v11 quad_perm:[2,3,0,1] row_mask:0xf bank_mask:0xf
    v_and_b32 v10, -2, v10
    v_and_b32 v11, -2, v11
L_flag:
    s_waitcnt vmcnt(0)
    v_readfirstlane_b32 s27, v12
    s_sub_u32 s29, s29, 1
    s_cbranch_scc1 L_flag1
    s_cmp_lg_u32 s27, 0
    s_cbranch_scc1 L_flag1
    global_load_dword v12, v67, s[18:19] sc1
    s_branch L_flag
L_flag1:
    s_xor_b32 s27, s27, s61
    s_cmp_eq_u32 s23, 0
    s_cselect_b32 s27, 0, s27
    v_mov_b32 v4, 0
    v_mov_b32 v5, s27
    ds_write_b32 v4, v5 offset:128
    s_mov_b32 s29, 0x400000
    s_cmp_lg_u32 s27, 0
    s_waitcnt lgkmcnt(0)
    s_cbranch_scc1 L_hthrough
    s_mov_b64 exec, 0x101
    global_store_dwordx2 v73, v[10:11], s[20:21]
    s_mov_b64 exec, -1
    s_mov_b32 s64, -1
    s_mov_b32 s65, 8
L_slice:
    s_bitcmp1_b32 s63, 3
    s_cselect_b32 s60, s59, s58
    v_lshlrev_b32 v56, 16, v48
    v_and_b32 v57, 0xffff0000, v48
    v_lshlrev_b32 v58, 16, v49
    v_and_b32 v59, 0xffff0000, v49
    v_mov_b32 v52, -1
    v_mov_b32 v53, -1
    v_mov_b32 v54, -1
    v_mov_b32 v55, -1
L_ml:
    global_load_dwordx2 v[50:51], v70, s[20:21] sc1
    global_load_dword v72, v67, s[18:19] offset:4 sc1
    s_sub_u32 s29, s29, 1
    s_waitcnt vmcnt(1)
    v_bitop3_b32 v4, v50, v51, 1 bitop3:0xa8
    s_cbranch_scc1 L_hend
    v_cmp_ne_u32 vcc, 0, v4
    s_cbranch_vccnz L_mlmiss
    v_max_f32 v10, s60, v50
    s_nop 1
    v_max_f32_dpp v10, v10, v10 row_ror:4 row_mask:0xf bank_mask:0xf
    s_nop 1
    v_max_f32_dpp v10, v10, v10 row_ror:8 row_mask:0xf bank_mask:0xf
    v_mov_b32 v4, v10
    s_nop 1
    v_permlane16_swap_b32 v10, v4
    v_max_f32 v10, v10, v4
    v_mov_b32 v4, v10
    s_nop 1
    v_permlane32_swap_b32 v10, v4
    v_max_f32 v10, v10, v4
    v_sub_f32 v50, v50, v10
    v_sub_f32 v74, s60, v10
    v_exp_f32 v50, v50
    v_exp_f32 v74, v74
    v_mul_f32 v11, v50, v51
    s_nop 1
    v_add_f32_dpp v11, v11, v11 row_ror:4 row_mask:0xf bank_mask:0xf
    s_nop 1
    v_add_f32_dpp v11, v11, v11 row_ror:8 row_mask:0xf bank_mask:0xf
    v_mov_b32 v4, v11
    s_nop 1
    v_permlane16_swap_b32 v11, v4
    v_add_f32 v11, v11, v4
    v_mov_b32 v4, v11
    s_nop 1
    v_permlane32_swap_b32 v11, v4
    v_add_f32 v11, v11, v4
    v_add_f32 v11, v11, v74
    v_rcp_f32 v11, v11
    v_mul_f32 v74, 0x3d800000, v74
    v_mul_f32 v50, v50, v11
    v_mul_f32 v74, v74, v11
    v_mov_b32 v51, v50
    v_mul_f32 v56, v74, v56
    v_mul_f32 v57, v74, v57
    v_mul_f32 v58, v74, v58
    v_mul_f32 v59, v74, v59
    s_cmp_eq_u32 s65, 0
    s_mov_b64 vcc, -1
    s_cbranch_scc1 L_poll0
    s_mov_b32 s65, 0
    s_barrier
L_poll0:
L_poll:
    s_mov_b64 exec, vcc
    global_load_dwordx4 v[52:55], v69, s[20:21] sc1
    s_mov_b64 exec, -1
    s_waitcnt vmcnt(2)
    v_or3_b32 v4, v52, v53, v54
    v_bitop3_b32 v4, v4, v55, 1 bitop3:0xa8
    v_cmp_ne_u32 vcc, 0, v4
    v_pk_fma_f32 v[60:61], v[50:51], v[52:53], v[56:57]
    v_pk_fma_f32 v[62:63], v[50:51], v[54:55], v[58:59]
    s_sub_u32 s29, s29, 1
    s_cbranch_scc1 L_hend
    v_permlane32_swap_b32 v60, v62
    v_permlane32_swap_b32 v61, v63
    s_cbranch_vccnz L_poll
    v_pk_add_f32 v[60:61], v[60:61], v[62:63]
    s_nop 1
    v_permlane16_swap_b32 v60, v61
    v_add_f32 v60, v60, v61
    s_nop 1
    v_add_f32_dpp v60, v60, v60 row_ror:8 row_mask:0xf bank_mask:0xf
    s_nop 1
    v_add_f32_dpp v60, v60, v60 row_ror:4 row_mask:0xf bank_mask:0xf
    v_cvt_pk_bf16_f32 v60, v60, v60
    global_store_short v71, v60, s[16:17]
    s_and_b32 s64, s64, s62
    s_cbranch_scc1 L_more
L_hend:
    s_endpgm
L_mlmiss:
    s_waitcnt vmcnt(0)
    v_readfirstlane_b32 s26, v72
    s_nop 0
    s_andn2_b32 s25, s26, s62
    s_or_b32 s62, s62, s26
    v_lshrrev_b32 v4, v68, s25
    v_and_b32 v4, 1, v4
    v_lshl_add_u32 v69, v4, 19, v69
    s_mul_i32 s26, s22, 1792
    s_add_u32 s26, s26, 0x80000
    v_mul_u32_u24 v6, 112, v68
    v_add_u32 v6, s26, v6
    v_mad_u32_u24 v70, v4, v6, v70
    s_cmp_eq_u32 s65, 0
    s_cbranch_scc1 L_ml
    s_sub_u32 s65, s65, 1
    s_cmp_lg_u32 s65, 0
    s_cbranch_scc1 L_ml
    s_barrier
    s_branch L_ml
L_more:
    s_cmp_lg_u32 s23, 0
    s_cbranch_scc1 L_hend
    s_ff1_i32_b32 s63, s64
    s_bitset0_b32 s64, s63
    s_waitcnt vmcnt(0)
    s_lshl_b32 s25, s22, 14
    s_lshl_b32 s26, s63, 6
    s_add_u32 s25, s25, s26
    v_and_b32 v5, 3, v1
    v_lshl_add_u32 v69, v68, 10, s25
    v_lshl_add_u32 v69, v5, 4, v69
    s_lshl_b32 s25, s22, 8
    s_and_b32 s26, s63, 8
    s_add_u32 s25, s25, s26
    s_add_u32 s25, s25, 0x40000
    v_lshl_add_u32 v70, v68, 4, s25
    s_and_b32 s25, s63, 3
    s_lshl_b32 s25, s25, 5
    s_and_b32 s30, s63, 4
    s_add_u32 s25, s25, s30
    s_lshl_b32 s30, s22, 7
    s_add_u32 s25, s25, s30
    v_lshl_add_u32 v5, v5, 3, s25
    v_lshlrev_b32 v74, 1, v5
    s_lshl4_add_u32 s30, s26, s30
    v_lshrrev_b32 v6, 4, v1
    v_add3_u32 v5, v5, v6, s30
    v_lshlrev_b32 v71, 1, v5
    global_load_dwordx2 v[48:49], v74, s[12:13]
    s_mov_b32 s25, s62
    v_lshrrev_b32 v4, v68, s25
    v_and_b32 v4, 1, v4
    v_lshl_add_u32 v69, v4, 19, v69
    s_mul_i32 s26, s22, 1792
    s_add_u32 s26, s26, 0x80000
    v_mul_u32_u24 v6, 112, v68
    v_add_u32 v6, s26, v6
    v_mad_u32_u24 v70, v4, v6, v70
    s_waitcnt vmcnt(0)
    s_branch L_slice
L_hthrough:
    s_mul_i32 s25, s31, 112
    s_add_u32 s25, s25, 0x80000
    v_add_u32 v73, s25, v73
    s_lshl_b32 s25, 1, s23
    v_mov_b32 v4, s25
    s_mov_b64 exec, 0x101
    global_store_dwordx2 v73, v[10:11], s[20:21] sc1
    s_mov_b64 exec, 1
    s_barrier
    s_waitcnt vmcnt(0)
    s_barrier
    global_atomic_or v67, v4, s[18:19] offset:4 sc1
    s_endpgm
.section .rodata,"a"
.p2align 6
.amdhsa_kernel standalone__tree_speculative_verify_tree_attention_over_candidate_token_tree__decode_kernel
  .amdhsa_next_free_vgpr 176
  .amdhsa_next_free_sgpr 72
  .amdhsa_accum_offset 176
  .amdhsa_group_segment_fixed_size 0
  .amdhsa_kernarg_size 72
  .amdhsa_user_sgpr_count 2
  .amdhsa_user_sgpr_kernarg_segment_ptr 1
  .amdhsa_system_sgpr_workgroup_id_x 1
.end_amdhsa_kernel
```
